```python
import torch

def _softmax(x, axis=-1):
    return torch.softmax(x, dim=axis)
def _gelu(x):
    return torch.nn.functional.gelu(x, approximate="tanh")
def _silu(x):
    return torch.nn.functional.silu(x)
def _sigmoid(x):
    return torch.sigmoid(x)
def _layernorm(x, axis=-1, eps=1e-5):
    m = x.mean(dim=axis, keepdim=True)
    v = x.var(dim=axis, keepdim=True, unbiased=False)
    return (x - m) / torch.sqrt(v + eps)
def _scatter_add(tgt, idx, src, axis=0):
    return tgt.clone().index_add_(axis, idx, src)
def _segment_sum(src, seg, n):
    out = torch.zeros((n,) + src.shape[1:], dtype=src.dtype)
    return out.index_add_(0, seg, src)
def _pad(x, pw):
    flat = tuple(v for pair in reversed(pw) for v in pair)
    return torch.nn.functional.pad(x, flat)

kernel_name = 'standalone__rezero__prompt'

def setup_inputs():

    _w = (lambda a: (lambda t: t.to(torch.bfloat16) if t.is_floating_point() else t)(torch.as_tensor(a)))
    B, S, D = 4, 2048, 448
    return {
        "x": _w((lambda *s: torch.randn(*s, dtype=torch.bfloat16) * 0.05)(B, S, D)),
        "fx": _w((lambda *s: torch.randn(*s, dtype=torch.bfloat16) * 0.4)(B, S, D)),
        "alpha": _w((lambda *s: torch.randn(*s, dtype=torch.bfloat16) * 0.4)(1) * 0.1),
    }

def reference(x, fx, alpha):
    return x + alpha * fx
```

```asm
; @launch grid=(256,1,1) block=(448,1,1) lds=0
.amdgcn_target "amdgcn-amd-amdhsa--gfx950"
.text
.globl standalone__rezero__prompt_kernel
.p2align 12
.p2align 8
.type standalone__rezero__prompt_kernel,@function
standalone__rezero__prompt_kernel:
    s_load_dwordx8 s[4:11], s[0:1], 0
    s_cmpk_ge_u32 s2, 256
    s_cbranch_scc1 L_end
    s_mulk_i32 s2, 28672
    v_lshl_add_u32 v2, v0, 4, s2
    s_movk_i32 s27, 7168
    v_add_u32 v3, s27, v2
    v_add_u32 v4, s27, v3
    v_add_u32 v5, s27, v4
    s_lshl_b32 s26, -1, 16
    s_waitcnt lgkmcnt(0)
    global_load_dwordx4 v[12:15], v2, s[6:7] nt
    global_load_dwordx4 v[8:11], v2, s[4:5] nt
    s_load_dword s24, s[8:9], 0
    global_load_dwordx4 v[20:23], v3, s[6:7] nt
    global_load_dwordx4 v[16:19], v3, s[4:5] nt
    s_waitcnt vmcnt(3) lgkmcnt(0)
    s_lshl_b32 s24, s24, 16
    v_lshlrev_b32 v40, 16, v12
    v_and_b32 v41, s26, v12
    v_lshlrev_b32 v42, 16, v13
    v_and_b32 v43, s26, v13
    v_lshlrev_b32 v44, 16, v14
    v_and_b32 v45, s26, v14
    v_lshlrev_b32 v46, 16, v15
    v_and_b32 v47, s26, v15
    v_pk_mul_f32 v[40:41], v[40:41], s[24:25] op_sel_hi:[1,0]
    v_pk_mul_f32 v[42:43], v[42:43], s[24:25] op_sel_hi:[1,0]
    v_pk_mul_f32 v[44:45], v[44:45], s[24:25] op_sel_hi:[1,0]
    v_pk_mul_f32 v[46:47], v[46:47], s[24:25] op_sel_hi:[1,0]
    v_cvt_pk_bf16_f32 v40, 0, v40
    v_cvt_pk_bf16_f32 v41, 0, v41
    v_cvt_pk_bf16_f32 v42, 0, v42
    v_cvt_pk_bf16_f32 v43, 0, v43
    v_cvt_pk_bf16_f32 v44, 0, v44
    v_cvt_pk_bf16_f32 v45, 0, v45
    v_cvt_pk_bf16_f32 v46, 0, v46
    v_cvt_pk_bf16_f32 v47, 0, v47
    s_waitcnt vmcnt(2)
    global_load_dwordx4 v[28:31], v4, s[6:7] nt
    global_load_dwordx4 v[24:27], v4, s[4:5] nt
    v_lshlrev_b32 v48, 16, v8
    v_and_b32 v49, s26, v8
    v_lshlrev_b32 v50, 16, v9
    v_and_b32 v51, s26, v9
    v_lshlrev_b32 v52, 16, v10
    v_and_b32 v53, s26, v10
    v_lshlrev_b32 v54, 16, v11
    v_and_b32 v55, s26, v11
    v_pk_add_f32 v[40:41], v[40:41], v[48:49]
    v_pk_add_f32 v[42:43], v[42:43], v[50:51]
    v_pk_add_f32 v[44:45], v[44:45], v[52:53]
    v_pk_add_f32 v[46:47], v[46:47], v[54:55]
    v_cvt_pk_bf16_f32 v8, v40, v41
    v_cvt_pk_bf16_f32 v9, v42, v43
    v_cvt_pk_bf16_f32 v10, v44, v45
    v_cvt_pk_bf16_f32 v11, v46, v47
    global_store_dwordx4 v2, v[8:11], s[10:11]
    s_waitcnt vmcnt(4)
    v_lshlrev_b32 v40, 16, v20
    v_and_b32 v41, s26, v20
    v_lshlrev_b32 v42, 16, v21
    v_and_b32 v43, s26, v21
    v_lshlrev_b32 v44, 16, v22
    v_and_b32 v45, s26, v22
    v_lshlrev_b32 v46, 16, v23
    v_and_b32 v47, s26, v23
    v_pk_mul_f32 v[40:41], v[40:41], s[24:25] op_sel_hi:[1,0]
    v_pk_mul_f32 v[42:43], v[42:43], s[24:25] op_sel_hi:[1,0]
    v_pk_mul_f32 v[44:45], v[44:45], s[24:25] op_sel_hi:[1,0]
    v_pk_mul_f32 v[46:47], v[46:47], s[24:25] op_sel_hi:[1,0]
    v_cvt_pk_bf16_f32 v40, 0, v40
    v_cvt_pk_bf16_f32 v41, 0, v41
    v_cvt_pk_bf16_f32 v42, 0, v42
    v_cvt_pk_bf16_f32 v43, 0, v43
    v_cvt_pk_bf16_f32 v44, 0, v44
    v_cvt_pk_bf16_f32 v45, 0, v45
    v_cvt_pk_bf16_f32 v46, 0, v46
    v_cvt_pk_bf16_f32 v47, 0, v47
    s_waitcnt vmcnt(3)
    global_load_dwordx4 v[36:39], v5, s[6:7] nt
    global_load_dwordx4 v[32:35], v5, s[4:5] nt
    v_lshlrev_b32 v48, 16, v16
    v_and_b32 v49, s26, v16
    v_lshlrev_b32 v50, 16, v17
    v_and_b32 v51, s26, v17
    v_lshlrev_b32 v52, 16, v18
    v_and_b32 v53, s26, v18
    v_lshlrev_b32 v54, 16, v19
    v_and_b32 v55, s26, v19
    v_pk_add_f32 v[40:41], v[40:41], v[48:49]
    v_pk_add_f32 v[42:43], v[42:43], v[50:51]
    v_pk_add_f32 v[44:45], v[44:45], v[52:53]
    v_pk_add_f32 v[46:47], v[46:47], v[54:55]
    v_cvt_pk_bf16_f32 v16, v40, v41
    v_cvt_pk_bf16_f32 v17, v42, v43
    v_cvt_pk_bf16_f32 v18, v44, v45
    v_cvt_pk_bf16_f32 v19, v46, v47
    global_store_dwordx4 v3, v[16:19], s[10:11]
    s_waitcnt vmcnt(5)
    v_lshlrev_b32 v40, 16, v28
    v_and_b32 v41, s26, v28
    v_lshlrev_b32 v42, 16, v29
    v_and_b32 v43, s26, v29
    v_lshlrev_b32 v44, 16, v30
    v_and_b32 v45, s26, v30
    v_lshlrev_b32 v46, 16, v31
    v_and_b32 v47, s26, v31
    v_pk_mul_f32 v[40:41], v[40:41], s[24:25] op_sel_hi:[1,0]
    v_pk_mul_f32 v[42:43], v[42:43], s[24:25] op_sel_hi:[1,0]
    v_pk_mul_f32 v[44:45], v[44:45], s[24:25] op_sel_hi:[1,0]
    v_pk_mul_f32 v[46:47], v[46:47], s[24:25] op_sel_hi:[1,0]
    v_cvt_pk_bf16_f32 v40, 0, v40
    v_cvt_pk_bf16_f32 v41, 0, v41
    v_cvt_pk_bf16_f32 v42, 0, v42
    v_cvt_pk_bf16_f32 v43, 0, v43
    v_cvt_pk_bf16_f32 v44, 0, v44
    v_cvt_pk_bf16_f32 v45, 0, v45
    v_cvt_pk_bf16_f32 v46, 0, v46
    v_cvt_pk_bf16_f32 v47, 0, v47
    s_waitcnt vmcnt(4)
    v_lshlrev_b32 v48, 16, v24
    v_and_b32 v49, s26, v24
    v_lshlrev_b32 v50, 16, v25
    v_and_b32 v51, s26, v25
    v_lshlrev_b32 v52, 16, v26
    v_and_b32 v53, s26, v26
    v_lshlrev_b32 v54, 16, v27
    v_and_b32 v55, s26, v27
    v_pk_add_f32 v[40:41], v[40:41], v[48:49]
    v_pk_add_f32 v[42:43], v[42:43], v[50:51]
    v_pk_add_f32 v[44:45], v[44:45], v[52:53]
    v_pk_add_f32 v[46:47], v[46:47], v[54:55]
    v_cvt_pk_bf16_f32 v24, v40, v41
    v_cvt_pk_bf16_f32 v25, v42, v43
    v_cvt_pk_bf16_f32 v26, v44, v45
    v_cvt_pk_bf16_f32 v27, v46, v47
    global_store_dwordx4 v4, v[24:27], s[10:11]
    s_waitcnt vmcnt(3)
    v_lshlrev_b32 v40, 16, v36
    v_and_b32 v41, s26, v36
    v_lshlrev_b32 v42, 16, v37
    v_and_b32 v43, s26, v37
    v_lshlrev_b32 v44, 16, v38
    v_and_b32 v45, s26, v38
    v_lshlrev_b32 v46, 16, v39
    v_and_b32 v47, s26, v39
    v_pk_mul_f32 v[40:41], v[40:41], s[24:25] op_sel_hi:[1,0]
    v_pk_mul_f32 v[42:43], v[42:43], s[24:25] op_sel_hi:[1,0]
    v_pk_mul_f32 v[44:45], v[44:45], s[24:25] op_sel_hi:[1,0]
    v_pk_mul_f32 v[46:47], v[46:47], s[24:25] op_sel_hi:[1,0]
    v_cvt_pk_bf16_f32 v40, 0, v40
    v_cvt_pk_bf16_f32 v41, 0, v41
    v_cvt_pk_bf16_f32 v42, 0, v42
    v_cvt_pk_bf16_f32 v43, 0, v43
    v_cvt_pk_bf16_f32 v44, 0, v44
    v_cvt_pk_bf16_f32 v45, 0, v45
    v_cvt_pk_bf16_f32 v46, 0, v46
    v_cvt_pk_bf16_f32 v47, 0, v47
    s_waitcnt vmcnt(2)
    v_lshlrev_b32 v48, 16, v32
    v_and_b32 v49, s26, v32
    v_lshlrev_b32 v50, 16, v33
    v_and_b32 v51, s26, v33
    v_lshlrev_b32 v52, 16, v34
    v_and_b32 v53, s26, v34
    v_lshlrev_b32 v54, 16, v35
    v_and_b32 v55, s26, v35
    v_pk_add_f32 v[40:41], v[40:41], v[48:49]
    v_pk_add_f32 v[42:43], v[42:43], v[50:51]
    v_pk_add_f32 v[44:45], v[44:45], v[52:53]
    v_pk_add_f32 v[46:47], v[46:47], v[54:55]
    v_cvt_pk_bf16_f32 v32, v40, v41
    v_cvt_pk_bf16_f32 v33, v42, v43
    v_cvt_pk_bf16_f32 v34, v44, v45
    v_cvt_pk_bf16_f32 v35, v46, v47
    global_store_dwordx4 v5, v[32:35], s[10:11]
L_end:
    s_endpgm
.section .rodata,"a"
.p2align 6
.amdhsa_kernel standalone__rezero__prompt_kernel
  .amdhsa_next_free_vgpr 56
  .amdhsa_next_free_sgpr 32
  .amdhsa_accum_offset 56
  .amdhsa_group_segment_fixed_size 0
  .amdhsa_kernarg_size 48
  .amdhsa_user_sgpr_count 2
  .amdhsa_user_sgpr_kernarg_segment_ptr 1
  .amdhsa_system_sgpr_workgroup_id_x 1
  .amdhsa_float_denorm_mode_32 3
.end_amdhsa_kernel
```
